```python
import torch

def _softmax(x, axis=-1):
    return torch.softmax(x, dim=axis)

def _gelu(x):
    return torch.nn.functional.gelu(x, approximate='tanh')

def _silu(x):
    return torch.nn.functional.silu(x)

def _sigmoid(x):
    return torch.sigmoid(x)

def _layernorm(x, axis=-1, eps=1e-05):
    m = x.mean(dim=axis, keepdim=True)
    v = x.var(dim=axis, keepdim=True, unbiased=False)
    return (x - m) / torch.sqrt(v + eps)

def _scatter_add(tgt, idx, src, axis=0):
    return tgt.clone().index_add_(axis, idx, src)

def _segment_sum(src, seg, n):
    out = torch.zeros((n,) + src.shape[1:], dtype=src.dtype)
    return out.index_add_(0, seg, src)

def _pad(x, pw):
    flat = tuple((v for pair in reversed(pw) for v in pair))
    return torch.nn.functional.pad(x, flat)
kernel_name = 'standalone__varlen_attn_packed__ragged'

def setup_inputs():

    _w = lambda a: (lambda t: t.to(torch.bfloat16) if t.is_floating_point() else t)(torch.as_tensor(a))
    cu = torch.tensor([0, 238, 376, 669, 835, 1320, 1545, 1865, 2058], dtype=torch.int64)
    T, H, D = (int(cu[-1]), 16, 192)
    return {'q': _w((lambda *s: torch.randn(*s, dtype=torch.bfloat16) * 0.8)(T, H, D)), 'k': _w((lambda *s: torch.randn(*s, dtype=torch.bfloat16) * 0.8)(T, H, D)), 'v': _w((lambda *s: torch.randn(*s, dtype=torch.bfloat16) * 0.05)(T, H, D)), 'cu': _w(cu)}

def reference(q, k, v, cu):
    T, H, D = q.shape
    out = torch.zeros_like(q)
    scale = D ** (-0.5)
    outs = []
    for i in range(len(cu) - 1):
        s, e = (int(cu[i]), int(cu[i + 1]))
        qi, ki, vi = (q[s:e].clone(), k[s:e].clone(), v[s:e].clone())
        p = _softmax(torch.einsum('qhd,khd->hqk', qi, ki) * scale, axis=-1)
        outs.append(torch.einsum('hqk,khd->qhd', p, vi))
    return torch.concatenate(outs, axis=0)
```

```asm
; @launch grid=(256,1,1) block=(512,1,1) lds=163840
.amdgcn_target "amdgcn-amd-amdhsa--gfx950"
.text
.globl standalone__varlen_attn_packed__ragged_kernel
.p2align 8
.type standalone__varlen_attn_packed__ragged_kernel,@function
standalone__varlen_attn_packed__ragged_kernel:
    s_load_dwordx4 s[4:7], s[0:1], 0
    s_load_dwordx2 s[8:9], s[0:1], 16
    s_getpc_b64 s[66:67]
L_pc1:
    s_lshl_b32 s48, s2, 2
    s_and_b32 s48, s48, 0x3c0
    s_add_u32 s48, s48, L_table-L_pc1
    s_load_dwordx16 s[32:47], s[66:67], s48
    s_load_dwordx2 s[10:11], s[0:1], 32
    v_lshrrev_b32 v1, 6, v0
    v_and_b32 v168, 63, v0
    s_cmp_ge_u32 s2, 256
    v_readfirstlane_b32 s31, v1
    s_cbranch_scc1 L_end
    s_and_b32 s49, s2, 15
    s_mul_i32 s30, s49, 384
    s_cmp_lt_u32 s31, 4
    s_cbranch_scc1 L_compute
L_loader:
    s_sub_u32 s31, s31, 4
    v_lshrrev_b32 v4, 3, v168
    v_lshl_add_u32 v4, s31, 3, v4
    v_and_b32 v5, 7, v168
    v_bfe_u32 v6, v4, 1, 3
    v_xor_b32 v6, v6, v5
    s_movk_i32 s28, 6144
    v_mul_u32_u24 v7, s28, v4
    v_lshl_add_u32 v2, v6, 4, v7
    v_and_b32 v6, 2, v4
    v_lshlrev_b32 v6, 1, v6
    v_xor_b32 v6, v6, v5
    v_lshl_add_u32 v3, v6, 4, v7
    s_mul_i32 s53, s31, 3072
    s_add_u32 s60, s53, 147456
    s_mov_b32 s15, 0x20000
    s_mov_b32 s19, 0x20000
    s_mov_b32 s65, 0
    s_mov_b32 s64, 4
    s_waitcnt lgkmcnt(0)
    s_mov_b32 s51, s37
    s_mov_b32 s63, s45
    s_add_u32 s48, s45, 2
    s_cmp_eq_u32 s45, 0
    s_cselect_b32 s48, 0, s48
    s_add_u32 s50, s37, 2
    s_add_u32 s50, s50, s48
    s_bfe_u32 s59, s39, 0x80008
L_seg0:
    s_mov_b64 s[12:13], s[4:5]
    s_mov_b32 s14, s35
    s_add_u32 s55, s32, s30
    v_mov_b32 v8, v2
    s_mov_b64 s[16:17], s[4:5]
    s_mov_b32 s18, s35
    s_add_u32 s56, s55, 196608
    v_mov_b32 v9, v2
    s_mov_b32 s57, 393216
    s_mov_b32 s61, 2
    s_mov_b32 s62, 0
    s_mov_b32 s52, -1
    s_cmp_lg_u32 s59, 0
    s_cbranch_scc1 L_slow0
L_go:
    s_add_u32 m0, s53, 0
    s_sub_u32 s50, s50, 1
    buffer_load_dwordx4 v8, s[12:15], s55 offen lds
L_go1:
    s_add_u32 m0, s53, 896
    s_sub_u32 s61, s61, 1
    buffer_load_dwordx4 v8, s[12:15], s55 offen offset:128 lds
L_go2:
    s_add_u32 m0, s53, 1792
    s_nop 0
    buffer_load_dwordx4 v8, s[12:15], s55 offen offset:256 lds
L_go3:
    s_add_u32 m0, s53, 12288
    s_add_u32 s55, s55, s57
    buffer_load_dwordx4 v9, s[16:19], s56 offen lds
L_go4:
    s_add_u32 m0, s53, 13184
    s_nop 0
    buffer_load_dwordx4 v9, s[16:19], s56 offen offset:128 lds
L_go5:
    s_add_u32 m0, s53, 14080
    s_cmp_eq_u32 s55, s52
    buffer_load_dwordx4 v9, s[16:19], s56 offen offset:256 lds
    s_cselect_b32 s55, s54, s55
    s_add_u32 s56, s56, s57
    s_cmp_eq_u32 s56, s52
    s_cselect_b32 s56, s54, s56
    s_add_u32 s53, s53, 24576
    s_cmp_ge_u32 s53, s60
    s_cselect_b32 s48, 147456, 0
    s_sub_u32 s53, s53, s48
    s_cmp_lg_u32 s64, 0
    s_cbranch_scc1 L_ld_plain
    s_sub_u32 s51, s51, 1
    s_min_u32 s48, s61, s51
    s_waitcnt vmcnt(12)
    s_cmp_lg_u32 s48, 0
    s_barrier
    s_cbranch_scc1 L_go
    s_cmp_lg_u32 s51, 0
    s_cbranch_scc1 L_ld_next
    s_mov_b32 s51, s63
    s_mov_b32 s64, 2
L_ld_next:
    s_cmp_eq_u32 s50, 0
    s_cbranch_scc1 L_ld_drain
    s_cmp_lg_u32 s61, 0
    s_cbranch_scc1 L_go
    s_add_u32 s62, s62, 1
    s_mov_b32 s61, 1
    s_cmp_eq_u32 s62, 3
    s_cbranch_scc1 L_seg3
    s_cmp_eq_u32 s62, 2
    s_cbranch_scc1 L_seg2
    s_cmp_eq_u32 s62, 4
    s_cbranch_scc1 L_seg4
    s_cmp_eq_u32 s62, 5
    s_cbranch_scc1 L_seg5
    s_mov_b64 s[12:13], s[6:7]
    s_mov_b32 s14, s36
    s_add_u32 s55, s34, s30
    s_mov_b64 s[16:17], s[6:7]
    s_mov_b32 s18, s36
    s_add_u32 s54, s33, s30
    s_mov_b32 s52, s55
    s_bfe_u32 s58, s39, 0x80010
    s_mul_i32 s58, s58, 196608
    s_add_u32 s58, s58, s54
    s_mov_b32 s56, s58
    s_mov_b32 s57, 196608
    s_branch L_go
L_seg2:
    s_mov_b64 s[12:13], s[8:9]
    v_mov_b32 v8, v3
    s_add_u32 s55, s34, s30
    s_branch L_go
L_seg3:
    s_mov_b32 s55, s58
    s_sub_u32 s61, s37, 3
    s_branch L_go
L_seg4:
    s_mov_b64 s[16:17], s[8:9]
    v_mov_b32 v9, v3
    s_add_u32 s56, s55, 196608
    s_cmp_eq_u32 s56, s52
    s_cselect_b32 s56, s54, s56
    s_branch L_go
L_seg5:
    s_mov_b64 s[32:33], s[40:41]
    s_mov_b64 s[34:35], s[42:43]
    s_mov_b64 s[36:37], s[44:45]
    s_mov_b64 s[38:39], s[46:47]
    s_branch L_seg0
L_slow0:
    s_add_u32 m0, s53, 0
    s_sub_u32 s50, s50, 1
    buffer_load_dwordx4 v8, s[12:15], s55 offen lds
    s_sub_u32 s59, s59, 1
    s_waitcnt vmcnt(0)
    s_cmp_eq_u32 s59, 0
    s_cbranch_scc1 L_go1
    s_add_u32 m0, s53, 896
    s_sub_u32 s61, s61, 1
    buffer_load_dwordx4 v8, s[12:15], s55 offen offset:128 lds
    s_sub_u32 s59, s59, 1
    s_waitcnt vmcnt(0)
    s_cmp_eq_u32 s59, 0
    s_cbranch_scc1 L_go2
    s_add_u32 m0, s53, 1792
    s_nop 0
    buffer_load_dwordx4 v8, s[12:15], s55 offen offset:256 lds
    s_sub_u32 s59, s59, 1
    s_waitcnt vmcnt(0)
    s_cmp_eq_u32 s59, 0
    s_cbranch_scc1 L_go3
    s_add_u32 m0, s53, 12288
    s_add_u32 s55, s55, s57
    buffer_load_dwordx4 v9, s[16:19], s56 offen lds
    s_sub_u32 s59, s59, 1
    s_waitcnt vmcnt(0)
    s_cmp_eq_u32 s59, 0
    s_cbranch_scc1 L_go4
    s_add_u32 m0, s53, 13184
    s_nop 0
    buffer_load_dwordx4 v9, s[16:19], s56 offen offset:128 lds
    s_sub_u32 s59, s59, 1
    s_waitcnt vmcnt(0)
    s_mov_b32 s59, 0
    s_branch L_go5
L_ld_plain:
    s_sub_u32 s64, s64, 1
    s_cmp_le_u32 s64, 0
    s_cbranch_scc1 L_ld_pl2
    s_bitcmp0_b32 s39, 25
    s_cbranch_scc1 L_ld_pl2
    s_waitcnt vmcnt(0)
L_ld_pl2:
    s_cmp_lg_u32 s64, 0
    s_cbranch_scc1 L_ld_next
    s_cmp_lg_u32 s65, 0
    s_mov_b32 s65, 0
    s_cbranch_scc1 L_ld_next
    s_waitcnt vmcnt(18)
    s_barrier
    s_waitcnt vmcnt(12)
    s_barrier
    s_branch L_ld_next
L_ld_drain:
    s_waitcnt vmcnt(6)
    s_barrier
    s_waitcnt vmcnt(0)
    s_barrier
    s_endpgm
L_compute:
    s_mov_b32 s27, 0x20000
    s_mov_b32 s52, 0x3dd53b95
    s_mov_b32 s53, 0xbdd53b95
    s_mov_b32 s54, 0x4b800000
    s_mov_b32 s50, 0
    s_mov_b32 s60, 0
    s_getpc_b64 s[58:59]
L_pc0:
    s_add_u32 s58, s58, L_slow-L_pc0
    s_addc_u32 s59, s59, 0
    v_and_b32 v169, 31, v168
    v_lshrrev_b32 v170, 5, v168
    v_bfe_u32 v171, v169, 1, 3
    v_xor_b32 v171, v171, v170
    v_lshrrev_b32 v170, 3, v169
    v_mul_u32_u24 v170, 3072, v170
    v_and_b32 v169, 7, v169
    v_lshl_add_u32 v169, v169, 7, v170
    v_xor_b32 v170, 0, v171
    v_lshl_add_u32 v152, v170, 4, v169
    v_xor_b32 v170, 2, v171
    v_lshl_add_u32 v153, v170, 4, v169
    v_xor_b32 v170, 4, v171
    v_lshl_add_u32 v154, v170, 4, v169
    v_xor_b32 v170, 6, v171
    v_lshl_add_u32 v155, v170, 4, v169
    v_bfe_u32 v169, v168, 2, 2
    v_lshrrev_b32 v170, 5, v168
    v_lshl_add_u32 v170, v170, 2, v169
    v_lshlrev_b32 v170, 7, v170
    v_bfe_u32 v171, v168, 4, 1
    v_lshl_add_u32 v170, v171, 5, v170
    v_and_b32 v171, 3, v168
    v_lshl_add_u32 v170, v171, 3, v170
    v_lshrrev_b32 v169, 1, v169
    v_lshl_add_u32 v156, v169, 6, v170
    v_xor_b32 v169, 1, v169
    v_lshl_add_u32 v157, v169, 6, v170
    s_lshl_b32 s48, s31, 12
    s_add_u32 s48, s48, 147456
    v_and_b32 v169, 31, v168
    v_lshrrev_b32 v170, 5, v168
    v_lshlrev_b32 v171, 7, v169
    v_lshl_add_u32 v171, v170, 3, v171
    v_and_b32 v169, 7, v169
    v_lshl_add_u32 v171, v169, 4, v171
    v_add_u32 v172, s48, v171
    v_lshrrev_b32 v169, 3, v168
    v_and_b32 v170, 7, v168
    v_xor_b32 v171, v169, v170
    v_lshlrev_b32 v171, 4, v171
    v_lshl_add_u32 v171, v169, 7, v171
    v_add_u32 v173, s48, v171
    s_movk_i32 s49, 6144
    v_mul_u32_u24 v169, s49, v169
    v_lshl_add_u32 v174, v170, 4, v169
    s_waitcnt lgkmcnt(0)
    s_mov_b64 s[24:25], s[10:11]
L_job:
    s_mov_b32 s26, s35
    s_and_b32 s48, s39, 0xff
    s_cmp_ge_u32 s31, s48
    s_cbranch_scc1 L_idle
    s_mov_b32 s48, s50
    s_add_u32 s50, s50, 24576
    s_cmp_eq_u32 s50, 147456
    s_cselect_b32 s50, 0, s50
    s_cmp_ge_u32 s31, 2
    s_cselect_b32 s48, s50, s48
    s_and_b32 s49, s31, 1
    s_mul_i32 s49, s49, 12288
    s_add_u32 s48, s48, s49
    v_add_u32 v158, s48, v152
    v_add_u32 v159, s48, v153
    v_add_u32 v160, s48, v154
    v_add_u32 v161, s48, v155
    s_add_u32 s50, s50, 24576
    s_cmp_eq_u32 s50, 147456
    s_cselect_b32 s50, 0, s50
    s_barrier
    s_barrier
    ds_read_b128 a[0:3], v158 offset:0
    ds_read_b128 a[4:7], v159 offset:0
    ds_read_b128 a[8:11], v160 offset:0
    ds_read_b128 a[12:15], v161 offset:0
    ds_read_b128 a[16:19], v158 offset:1024
    ds_read_b128 a[20:23], v159 offset:1024
    ds_read_b128 a[24:27], v160 offset:1024
    ds_read_b128 a[28:31], v161 offset:1024
    ds_read_b128 a[32:35], v158 offset:2048
    ds_read_b128 a[36:39], v159 offset:2048
    ds_read_b128 a[40:43], v160 offset:2048
    ds_read_b128 a[44:47], v161 offset:2048
    v_mov_b32 v165, 0
    v_lshrrev_b32 v169, 5, v168
    v_lshlrev_b32 v169, 2, v169
    s_sub_u32 s48, s38, 1
    v_sub_u32 v169, s48, v169
    v_subrev_u32 v170, 0, v169
    v_and_b32 v112, 0xff800000, v170
    v_subrev_u32 v170, 1, v169
    v_and_b32 v113, 0xff800000, v170
    v_subrev_u32 v170, 2, v169
    v_and_b32 v114, 0xff800000, v170
    v_subrev_u32 v170, 3, v169
    v_and_b32 v115, 0xff800000, v170
    v_subrev_u32 v170, 8, v169
    v_and_b32 v116, 0xff800000, v170
    v_subrev_u32 v170, 9, v169
    v_and_b32 v117, 0xff800000, v170
    v_subrev_u32 v170, 10, v169
    v_and_b32 v118, 0xff800000, v170
    v_subrev_u32 v170, 11, v169
    v_and_b32 v119, 0xff800000, v170
    v_subrev_u32 v170, 16, v169
    v_and_b32 v120, 0xff800000, v170
    v_subrev_u32 v170, 17, v169
    v_and_b32 v121, 0xff800000, v170
    v_subrev_u32 v170, 18, v169
    v_and_b32 v122, 0xff800000, v170
    v_subrev_u32 v170, 19, v169
    v_and_b32 v123, 0xff800000, v170
    v_subrev_u32 v170, 24, v169
    v_and_b32 v124, 0xff800000, v170
    v_subrev_u32 v170, 25, v169
    v_and_b32 v125, 0xff800000, v170
    v_subrev_u32 v170, 26, v169
    v_and_b32 v126, 0xff800000, v170
    v_subrev_u32 v170, 27, v169
    v_and_b32 v127, 0xff800000, v170
    s_mul_i32 s48, s31, 196608
    s_add_u32 s55, s48, s32
    s_add_u32 s55, s55, s30
    s_add_u32 s13, s55, 49152
    s_add_u32 s14, s55, 98304
    s_add_u32 s15, s55, 147456
    s_sub_u32 s51, s37, 3
    v_add_u32 v158, s50, v152
    v_add_u32 v159, s50, v153
    v_add_u32 v160, s50, v154
    v_add_u32 v161, s50, v155
    s_add_u32 s50, s50, 24576
    s_cmp_eq_u32 s50, 147456
    s_cselect_b32 s50, 0, s50
    v_add_u32 v162, s50, v156
    v_add_u32 v163, s50, v157
    s_waitcnt lgkmcnt(0)
    s_barrier
    ds_read_b128 a[48:51], v158 offset:0
    ds_read_b128 a[52:55], v159 offset:0
    ds_read_b128 a[56:59], v160 offset:0
    ds_read_b128 a[60:63], v161 offset:0
    ds_read_b128 a[64:67], v158 offset:1024
    ds_read_b128 a[68:71], v159 offset:1024
    s_waitcnt lgkmcnt(4)
    v_mfma_f32_32x32x16_bf16 v[112:127], a[48:51], a[0:3], v[112:127]
    ds_read_b128 a[72:75], v160 offset:1024
    v_mfma_f32_32x32x16_bf16 v[112:127], a[52:55], a[4:7], v[112:127]
    ds_read_b128 a[76:79], v161 offset:1024
    s_waitcnt lgkmcnt(4)
    v_mfma_f32_32x32x16_bf16 v[112:127], a[56:59], a[8:11], v[112:127]
    ds_read_b128 a[48:51], v158 offset:2048
    v_mfma_f32_32x32x16_bf16 v[112:127], a[60:63], a[12:15], v[112:127]
    ds_read_b128 a[52:55], v159 offset:2048
    s_waitcnt lgkmcnt(4)
    v_mfma_f32_32x32x16_bf16 v[112:127], a[64:67], a[16:19], v[112:127]
    ds_read_b128 a[56:59], v160 offset:2048
    v_mfma_f32_32x32x16_bf16 v[112:127], a[68:71], a[20:23], v[112:127]
    ds_read_b128 a[60:63], v161 offset:2048
    s_waitcnt lgkmcnt(4)
    v_mfma_f32_32x32x16_bf16 v[112:127], a[72:75], a[24:27], v[112:127]
    ds_read_b128 a[64:67], v158 offset:12288
    v_mfma_f32_32x32x16_bf16 v[112:127], a[76:79], a[28:31], v[112:127]
    ds_read_b128 a[68:71], v159 offset:12288
    s_waitcnt lgkmcnt(4)
    v_mfma_f32_32x32x16_bf16 v[112:127], a[48:51], a[32:35], v[112:127]
    ds_read_b128 a[72:75], v160 offset:12288
    v_mfma_f32_32x32x16_bf16 v[112:127], a[52:55], a[36:39], v[112:127]
    ds_read_b128 a[76:79], v161 offset:12288
    s_waitcnt lgkmcnt(4)
    v_mfma_f32_32x32x16_bf16 v[112:127], a[56:59], a[40:43], v[112:127]
    ds_read_b128 a[48:51], v158 offset:13312
    v_mfma_f32_32x32x16_bf16 v[112:127], a[60:63], a[44:47], v[112:127]
    ds_read_b128 a[52:55], v159 offset:13312
    s_waitcnt lgkmcnt(4)
    v_mfma_f32_32x32x16_bf16 v[96:111], a[64:67], a[0:3], 0
    ds_read_b128 a[56:59], v160 offset:13312
    s_nop 7
    v_mfma_f32_32x32x16_bf16 v[96:111], a[68:71], a[4:7], v[96:111]
    ds_read_b128 a[60:63], v161 offset:13312
    v_max3_f32 v166, v112, v113, v114
    v_max3_f32 v167, v115, v116, v117
    v_max3_f32 v166, v166, v118, v119
    v_max3_f32 v167, v167, v120, v121
    v_max3_f32 v166, v166, v122, v123
    s_waitcnt lgkmcnt(4)
    v_mfma_f32_32x32x16_bf16 v[96:111], a[72:75], a[8:11], v[96:111]
    ds_read_b128 a[64:67], v158 offset:14336
    v_max3_f32 v167, v167, v124, v125
    v_max3_f32 v166, v166, v126, v127
    v_max_f32 v166, v166, v167
    v_mov_b32 v167, v166
    s_nop 1
    v_permlane32_swap_b32 v166, v167
    v_mfma_f32_32x32x16_bf16 v[96:111], a[76:79], a[12:15], v[96:111]
    ds_read_b128 a[68:71], v159 offset:14336
    v_max_f32 v166, v166, v167
    v_mul_f32 v164, s53, v166
    v_fma_f32 v112, v112, s52, v164
    v_fma_f32 v113, v113, s52, v164
    s_waitcnt lgkmcnt(4)
    v_mfma_f32_32x32x16_bf16 v[96:111], a[48:51], a[16:19], v[96:111]
    ds_read_b128 a[72:75], v160 offset:14336
    v_fma_f32 v114, v114, s52, v164
    v_fma_f32 v115, v115, s52, v164
    v_exp_f32 v128, v112
    v_exp_f32 v129, v113
    v_mfma_f32_32x32x16_bf16 v[96:111], a[52:55], a[20:23], v[96:111]
    s_barrier
    ds_read_b128 a[76:79], v161 offset:14336
    v_fma_f32 v116, v116, s52, v164
    v_fma_f32 v117, v117, s52, v164
    v_exp_f32 v130, v114
    s_waitcnt lgkmcnt(4)
    v_mfma_f32_32x32x16_bf16 v[96:111], a[56:59], a[24:27], v[96:111]
    ds_read_b64_tr_b16 a[48:49], v162 offset:0
    ds_read_b64_tr_b16 a[50:51], v162 offset:3072
    v_fma_f32 v118, v118, s52, v164
    v_fma_f32 v119, v119, s52, v164
    v_exp_f32 v131, v115
    v_add_f32 v166, v128, v130
    v_mfma_f32_32x32x16_bf16 v[96:111], a[60:63], a[28:31], v[96:111]
    ds_read_b64_tr_b16 a[52:53], v163 offset:0
    ds_read_b64_tr_b16 a[54:55], v163 offset:3072
    v_exp_f32 v132, v116
    v_exp_f32 v133, v117
    s_waitcnt lgkmcnt(6)
    v_mfma_f32_32x32x16_bf16 v[96:111], a[64:67], a[32:35], v[96:111]
    ds_read_b64_tr_b16 a[56:57], v162 offset:1024
    ds_read_b64_tr_b16 a[58:59], v162 offset:4096
    v_exp_f32 v134, v118
    v_exp_f32 v135, v119
    v_add_f32 v167, v129, v131
    v_mfma_f32_32x32x16_bf16 v[96:111], a[68:71], a[36:39], v[96:111]
    ds_read_b64_tr_b16 a[60:61], v163 offset:1024
    ds_read_b64_tr_b16 a[62:63], v163 offset:4096
    v_add_f32 v166, v166, v132
    v_add_f32 v167, v167, v133
    v_add_f32 v166, v166, v134
    v_add_f32 v167, v167, v135
    s_waitcnt lgkmcnt(8)
    v_mfma_f32_32x32x16_bf16 v[96:111], a[72:75], a[40:43], v[96:111]
    ds_read_b64_tr_b16 a[64:65], v162 offset:2048
    ds_read_b64_tr_b16 a[66:67], v162 offset:5120
    v_cvt_pk_bf16_f32 v144, v128, v129
    v_cvt_pk_bf16_f32 v145, v130, v131
    v_cvt_pk_bf16_f32 v146, v132, v133
    v_cvt_pk_bf16_f32 v147, v134, v135
    v_add_f32 v165, v166, v167
    v_mfma_f32_32x32x16_bf16 v[96:111], a[76:79], a[44:47], v[96:111]
    ds_read_b64_tr_b16 a[68:69], v163 offset:2048
    ds_read_b64_tr_b16 a[70:71], v163 offset:5120
    v_add_u32 v158, s50, v152
    v_add_u32 v159, s50, v153
    v_add_u32 v160, s50, v154
    v_add_u32 v161, s50, v155
    s_cmp_gt_u32 s38, 16
    s_cbranch_scc1 L_smB
L_smB_ret:
    s_nop 7
    s_waitcnt lgkmcnt(8)
    v_mfma_f32_32x32x16_bf16 v[0:15], a[48:51], v[144:147], 0
    ds_read_b128 a[48:51], v158 offset:12288
    v_fma_f32 v112, v96, s52, v164
    v_fma_f32 v113, v97, s52, v164
    v_fma_f32 v114, v98, s52, v164
    v_exp_f32 v128, v112
    v_mfma_f32_32x32x16_bf16 v[16:31], a[52:55], v[144:147], 0
    ds_read_b128 a[52:55], v159 offset:12288
    v_fma_f32 v115, v99, s52, v164
    v_fma_f32 v116, v100, s52, v164
    v_fma_f32 v117, v101, s52, v164
    v_exp_f32 v129, v113
    s_waitcnt lgkmcnt(6)
    v_mfma_f32_32x32x16_bf16 v[32:47], a[56:59], v[144:147], 0
    ds_read_b128 a[56:59], v160 offset:12288
    v_fma_f32 v118, v102, s52, v164
    v_fma_f32 v119, v103, s52, v164
    v_fma_f32 v120, v104, s52, v164
    v_exp_f32 v130, v114
    v_mfma_f32_32x32x16_bf16 v[48:63], a[60:63], v[144:147], 0
    ds_read_b128 a[60:63], v161 offset:12288
    v_fma_f32 v121, v105, s52, v164
    v_fma_f32 v122, v106, s52, v164
    v_fma_f32 v123, v107, s52, v164
    v_exp_f32 v131, v115
    s_waitcnt lgkmcnt(4)
    v_mfma_f32_32x32x16_bf16 v[64:79], a[64:67], v[144:147], 0
    ds_read_b128 a[64:67], v158 offset:13312
    v_fma_f32 v124, v108, s52, v164
    v_fma_f32 v125, v109, s52, v164
    v_fma_f32 v126, v110, s52, v164
    v_exp_f32 v132, v116
    v_add_f32 v166, v128, v130
    v_mfma_f32_32x32x16_bf16 v[80:95], a[68:71], v[144:147], 0
    ds_read_b128 a[68:71], v159 offset:13312
    v_fma_f32 v127, v111, s52, v164
    v_exp_f32 v133, v117
    v_exp_f32 v134, v118
    s_cmp_gt_u32 s38, 16
    s_cbranch_scc1 L_ks1
L_ks1_ret:
    s_waitcnt lgkmcnt(4)
    v_mfma_f32_32x32x16_bf16 v[96:111], a[48:51], a[0:3], 0
    ds_read_b128 a[48:51], v160 offset:13312
    s_add_u32 s50, s50, 24576
    s_cmp_eq_u32 s50, 147456
    s_cselect_b32 s50, 0, s50
    v_exp_f32 v135, v119
    v_add_f32 v167, v129, v131
    v_mfma_f32_32x32x16_bf16 v[96:111], a[52:55], a[4:7], v[96:111]
    ds_read_b128 a[52:55], v161 offset:13312
    v_exp_f32 v136, v120
    v_exp_f32 v137, v121
    v_add_f32 v166, v166, v132
    s_waitcnt lgkmcnt(4)
    v_mfma_f32_32x32x16_bf16 v[96:111], a[56:59], a[8:11], v[96:111]
    ds_read_b128 a[56:59], v158 offset:14336
    v_exp_f32 v138, v122
    v_exp_f32 v139, v123
    v_add_f32 v167, v167, v133
    v_add_f32 v166, v166, v134
    v_mfma_f32_32x32x16_bf16 v[96:111], a[60:63], a[12:15], v[96:111]
    ds_read_b128 a[60:63], v159 offset:14336
    v_exp_f32 v140, v124
    v_exp_f32 v141, v125
    v_add_f32 v167, v167, v135
    s_waitcnt lgkmcnt(4)
    v_mfma_f32_32x32x16_bf16 v[96:111], a[64:67], a[16:19], v[96:111]
    ds_read_b128 a[64:67], v160 offset:14336
    v_exp_f32 v142, v126
    v_exp_f32 v143, v127
    v_add_f32 v166, v166, v136
    v_add_f32 v167, v167, v137
    v_add_u32 v162, s50, v156
    v_add_u32 v163, s50, v157
    v_mfma_f32_32x32x16_bf16 v[96:111], a[68:71], a[20:23], v[96:111]
    s_barrier
    ds_read_b128 a[68:71], v161 offset:14336
    v_add_f32 v166, v166, v138
    s_waitcnt lgkmcnt(4)
    v_mfma_f32_32x32x16_bf16 v[96:111], a[48:51], a[24:27], v[96:111]
    ds_read_b64_tr_b16 a[48:49], v162 offset:0
    ds_read_b64_tr_b16 a[50:51], v162 offset:3072
    v_add_f32 v167, v167, v139
    v_add_f32 v166, v166, v140
    v_add_f32 v167, v167, v141
    v_add_f32 v166, v166, v142
    v_add_f32 v167, v167, v143
    v_mfma_f32_32x32x16_bf16 v[96:111], a[52:55], a[28:31], v[96:111]
    ds_read_b64_tr_b16 a[52:53], v163 offset:0
    ds_read_b64_tr_b16 a[54:55], v163 offset:3072
    v_add_f32 v166, v166, v167
    v_cvt_pk_bf16_f32 v144, v128, v129
    v_cvt_pk_bf16_f32 v145, v130, v131
    v_cvt_pk_bf16_f32 v146, v132, v133
    s_waitcnt lgkmcnt(6)
    v_mfma_f32_32x32x16_bf16 v[96:111], a[56:59], a[32:35], v[96:111]
    ds_read_b64_tr_b16 a[56:57], v162 offset:1024
    ds_read_b64_tr_b16 a[58:59], v162 offset:4096
    v_cvt_pk_bf16_f32 v147, v134, v135
    v_cvt_pk_bf16_f32 v148, v136, v137
    v_cvt_pk_bf16_f32 v149, v138, v139
    v_cvt_pk_bf16_f32 v150, v140, v141
    v_cvt_pk_bf16_f32 v151, v142, v143
    v_mfma_f32_32x32x16_bf16 v[96:111], a[60:63], a[36:39], v[96:111]
    ds_read_b64_tr_b16 a[60:61], v163 offset:1024
    ds_read_b64_tr_b16 a[62:63], v163 offset:4096
    v_cmp_nge_f32 vcc, s54, v166
    s_cbranch_vccnz L_b0_slow
L_b0_ret:
    v_add_f32 v165, v165, v166
    v_add_u32 v158, s50, v152
    s_waitcnt lgkmcnt(8)
    v_mfma_f32_32x32x16_bf16 v[96:111], a[64:67], a[40:43], v[96:111]
    ds_read_b64_tr_b16 a[64:65], v162 offset:2048
    ds_read_b64_tr_b16 a[66:67], v162 offset:5120
    v_add_u32 v159, s50, v153
    v_add_u32 v160, s50, v154
    v_add_u32 v161, s50, v155
    v_mfma_f32_32x32x16_bf16 v[96:111], a[68:71], a[44:47], v[96:111]
    ds_read_b64_tr_b16 a[68:69], v163 offset:2048
    ds_read_b64_tr_b16 a[70:71], v163 offset:5120
.p2align 3
L_body:
    s_waitcnt lgkmcnt(8)
    v_mfma_f32_32x32x16_bf16 v[0:15], a[48:51], v[144:147], v[0:15]
    ds_read_b64_tr_b16 a[72:73], v162 offset:6144
    ds_read_b64_tr_b16 a[74:75], v162 offset:9216
    s_add_u32 s50, s50, 24576
    s_cmp_eq_u32 s50, 147456
    s_cselect_b32 s50, 0, s50
    v_mfma_f32_32x32x16_bf16 v[16:31], a[52:55], v[144:147], v[16:31]
    ds_read_b64_tr_b16 a[76:77], v163 offset:6144
    ds_read_b64_tr_b16 a[78:79], v163 offset:9216
    s_sub_u32 s51, s51, 1
    s_waitcnt lgkmcnt(8)
    v_mfma_f32_32x32x16_bf16 v[32:47], a[56:59], v[144:147], v[32:47]
    ds_read_b64_tr_b16 a[48:49], v162 offset:7168
    ds_read_b64_tr_b16 a[50:51], v162 offset:10240
    v_fma_f32 v112, v96, s52, v164
    v_fma_f32 v113, v97, s52, v164
    v_exp_f32 v128, v112
    v_mfma_f32_32x32x16_bf16 v[48:63], a[60:63], v[144:147], v[48:63]
    ds_read_b64_tr_b16 a[52:53], v163 offset:7168
    ds_read_b64_tr_b16 a[54:55], v163 offset:10240
    v_fma_f32 v114, v98, s52, v164
    v_fma_f32 v115, v99, s52, v164
    s_waitcnt lgkmcnt(8)
    v_mfma_f32_32x32x16_bf16 v[64:79], a[64:67], v[144:147], v[64:79]
    ds_read_b64_tr_b16 a[56:57], v162 offset:8192
    ds_read_b64_tr_b16 a[58:59], v162 offset:11264
    v_fma_f32 v116, v100, s52, v164
    v_fma_f32 v117, v101, s52, v164
    v_exp_f32 v129, v113
    v_mfma_f32_32x32x16_bf16 v[80:95], a[68:71], v[144:147], v[80:95]
    ds_read_b64_tr_b16 a[60:61], v163 offset:8192
    ds_read_b64_tr_b16 a[62:63], v163 offset:11264
    v_fma_f32 v118, v102, s52, v164
    v_fma_f32 v119, v103, s52, v164
    v_cvt_pk_bf16_f32 v144, v128, v129
    s_waitcnt lgkmcnt(8)
    v_mfma_f32_32x32x16_bf16 v[0:15], a[72:75], v[148:151], v[0:15]
    ds_read_b128 a[64:67], v158 offset:12288
    v_fma_f32 v120, v104, s52, v164
    v_fma_f32 v121, v105, s52, v164
    v_exp_f32 v130, v114
    v_add_u32 v162, s50, v156
    v_mfma_f32_32x32x16_bf16 v[16:31], a[76:79], v[148:151], v[16:31]
    ds_read_b128 a[68:71], v159 offset:12288
    v_fma_f32 v122, v106, s52, v164
    v_fma_f32 v123, v107, s52, v164
    v_exp_f32 v131, v115
    s_waitcnt lgkmcnt(6)
    v_mfma_f32_32x32x16_bf16 v[32:47], a[48:51], v[148:151], v[32:47]
    ds_read_b128 a[72:75], v160 offset:12288
    v_fma_f32 v124, v108, s52, v164
    v_fma_f32 v125, v109, s52, v164
    v_exp_f32 v132, v116
    v_add_f32 v166, v128, v130
    v_mfma_f32_32x32x16_bf16 v[48:63], a[52:55], v[148:151], v[48:63]
    ds_read_b128 a[76:79], v161 offset:12288
    v_fma_f32 v126, v110, s52, v164
    v_fma_f32 v127, v111, s52, v164
    v_exp_f32 v133, v117
    s_waitcnt lgkmcnt(4)
    v_mfma_f32_32x32x16_bf16 v[64:79], a[56:59], v[148:151], v[64:79]
    ds_read_b128 a[48:51], v158 offset:13312
    v_exp_f32 v134, v118
    v_add_f32 v167, v129, v131
    v_add_f32 v166, v166, v132
    v_add_f32 v167, v167, v133
    v_mfma_f32_32x32x16_bf16 v[80:95], a[60:63], v[148:151], v[80:95]
    ds_read_b128 a[52:55], v159 offset:13312
    v_exp_f32 v135, v119
    v_add_f32 v166, v166, v134
    v_add_f32 v167, v167, v135
    s_waitcnt lgkmcnt(4)
    v_mfma_f32_32x32x16_bf16 v[96:111], a[64:67], a[0:3], 0
    ds_read_b128 a[56:59], v160 offset:13312
    v_exp_f32 v136, v120
    v_cvt_pk_bf16_f32 v145, v130, v131
    v_add_f32 v166, v166, v136
    v_cvt_pk_bf16_f32 v146, v132, v133
    v_mfma_f32_32x32x16_bf16 v[96:111], a[68:71], a[4:7], v[96:111]
    ds_read_b128 a[60:63], v161 offset:13312
    v_exp_f32 v137, v121
    v_cvt_pk_bf16_f32 v147, v134, v135
    v_add_f32 v167, v167, v137
    s_waitcnt lgkmcnt(4)
    v_mfma_f32_32x32x16_bf16 v[96:111], a[72:75], a[8:11], v[96:111]
    ds_read_b128 a[64:67], v158 offset:14336
    v_exp_f32 v138, v122
    v_cvt_pk_bf16_f32 v148, v136, v137
    v_add_f32 v166, v166, v138
    v_add_u32 v163, s50, v157
    v_mfma_f32_32x32x16_bf16 v[96:111], a[76:79], a[12:15], v[96:111]
    ds_read_b128 a[68:71], v159 offset:14336
    v_exp_f32 v139, v123
    s_waitcnt lgkmcnt(4)
    v_mfma_f32_32x32x16_bf16 v[96:111], a[48:51], a[16:19], v[96:111]
    ds_read_b128 a[72:75], v160 offset:14336
    v_exp_f32 v140, v124
    v_add_f32 v167, v167, v139
    v_add_f32 v166, v166, v140
    v_cvt_pk_bf16_f32 v149, v138, v139
    v_mfma_f32_32x32x16_bf16 v[96:111], a[52:55], a[20:23], v[96:111]
    s_barrier
    ds_read_b128 a[76:79], v161 offset:14336
    s_waitcnt lgkmcnt(4)
    v_mfma_f32_32x32x16_bf16 v[96:111], a[56:59], a[24:27], v[96:111]
    ds_read_b64_tr_b16 a[48:49], v162 offset:0
    ds_read_b64_tr_b16 a[50:51], v162 offset:3072
    v_exp_f32 v141, v125
    v_add_u32 v158, s50, v152
    v_add_f32 v167, v167, v141
    v_mfma_f32_32x32x16_bf16 v[96:111], a[60:63], a[28:31], v[96:111]
    ds_read_b64_tr_b16 a[52:53], v163 offset:0
    ds_read_b64_tr_b16 a[54:55], v163 offset:3072
    v_exp_f32 v142, v126
    v_cvt_pk_bf16_f32 v150, v140, v141
    s_waitcnt lgkmcnt(6)
    v_mfma_f32_32x32x16_bf16 v[96:111], a[64:67], a[32:35], v[96:111]
    ds_read_b64_tr_b16 a[56:57], v162 offset:1024
    ds_read_b64_tr_b16 a[58:59], v162 offset:4096
    v_exp_f32 v143, v127
    v_add_f32 v166, v166, v142
    v_add_f32 v167, v167, v143
    v_mfma_f32_32x32x16_bf16 v[96:111], a[68:71], a[36:39], v[96:111]
    ds_read_b64_tr_b16 a[60:61], v163 offset:1024
    ds_read_b64_tr_b16 a[62:63], v163 offset:4096
    v_add_f32 v166, v166, v167
    v_cvt_pk_bf16_f32 v151, v142, v143
    v_cmp_nge_f32 vcc, s54, v166
    s_waitcnt lgkmcnt(8)
    v_mfma_f32_32x32x16_bf16 v[96:111], a[72:75], a[40:43], v[96:111]
    ds_read_b64_tr_b16 a[64:65], v162 offset:2048
    ds_read_b64_tr_b16 a[66:67], v162 offset:5120
    s_cbranch_vccnz L_body_slow
L_body_ret:
    v_add_f32 v165, v165, v166
    v_add_u32 v159, s50, v153
    v_add_u32 v160, s50, v154
    v_mfma_f32_32x32x16_bf16 v[96:111], a[76:79], a[44:47], v[96:111]
    ds_read_b64_tr_b16 a[68:69], v163 offset:2048
    ds_read_b64_tr_b16 a[70:71], v163 offset:5120
    v_add_u32 v161, s50, v155
    s_cmp_lg_u32 s51, 0
    s_cbranch_scc1 L_body
    s_waitcnt lgkmcnt(8)
    v_mfma_f32_32x32x16_bf16 v[0:15], a[48:51], v[144:147], v[0:15]
    ds_read_b64_tr_b16 a[72:73], v162 offset:6144
    ds_read_b64_tr_b16 a[74:75], v162 offset:9216
    s_nop 3
    v_mfma_f32_32x32x16_bf16 v[16:31], a[52:55], v[144:147], v[16:31]
    ds_read_b64_tr_b16 a[76:77], v163 offset:6144
    ds_read_b64_tr_b16 a[78:79], v163 offset:9216
    s_waitcnt lgkmcnt(8)
    v_mfma_f32_32x32x16_bf16 v[32:47], a[56:59], v[144:147], v[32:47]
    ds_read_b64_tr_b16 a[48:49], v162 offset:7168
    ds_read_b64_tr_b16 a[50:51], v162 offset:10240
    v_fma_f32 v112, v96, s52, v164
    v_fma_f32 v113, v97, s52, v164
    v_exp_f32 v128, v112
    v_exp_f32 v129, v113
    v_mfma_f32_32x32x16_bf16 v[48:63], a[60:63], v[144:147], v[48:63]
    ds_read_b64_tr_b16 a[52:53], v163 offset:7168
    ds_read_b64_tr_b16 a[54:55], v163 offset:10240
    v_fma_f32 v114, v98, s52, v164
    v_fma_f32 v115, v99, s52, v164
    v_exp_f32 v130, v114
    v_exp_f32 v131, v115
    v_add_f32 v166, v128, v130
    s_waitcnt lgkmcnt(8)
    v_mfma_f32_32x32x16_bf16 v[64:79], a[64:67], v[144:147], v[64:79]
    ds_read_b64_tr_b16 a[56:57], v162 offset:8192
    ds_read_b64_tr_b16 a[58:59], v162 offset:11264
    v_fma_f32 v116, v100, s52, v164
    v_fma_f32 v117, v101, s52, v164
    v_exp_f32 v132, v116
    v_exp_f32 v133, v117
    v_add_f32 v167, v129, v131
    v_add_f32 v166, v166, v132
    v_mfma_f32_32x32x16_bf16 v[80:95], a[68:71], v[144:147], v[80:95]
    ds_read_b64_tr_b16 a[60:61], v163 offset:8192
    ds_read_b64_tr_b16 a[62:63], v163 offset:11264
    v_fma_f32 v118, v102, s52, v164
    v_fma_f32 v119, v103, s52, v164
    v_exp_f32 v134, v118
    v_exp_f32 v135, v119
    v_add_f32 v167, v167, v133
    s_waitcnt lgkmcnt(8)
    v_mfma_f32_32x32x16_bf16 v[0:15], a[72:75], v[148:151], v[0:15]
    ds_read_b64_tr_b16 a[64:65], v162 offset:12288
    ds_read_b64_tr_b16 a[66:67], v162 offset:15360
    v_fma_f32 v120, v104, s52, v164
    v_fma_f32 v121, v105, s52, v164
    v_exp_f32 v136, v120
    v_exp_f32 v137, v121
    v_add_f32 v166, v166, v134
    v_add_f32 v167, v167, v135
    v_mfma_f32_32x32x16_bf16 v[16:31], a[76:79], v[148:151], v[16:31]
    ds_read_b64_tr_b16 a[68:69], v162 offset:18432
    ds_read_b64_tr_b16 a[70:71], v162 offset:21504
    v_fma_f32 v122, v106, s52, v164
    v_fma_f32 v123, v107, s52, v164
    v_exp_f32 v138, v122
    v_exp_f32 v139, v123
    v_add_f32 v166, v166, v136
    s_waitcnt lgkmcnt(8)
    v_mfma_f32_32x32x16_bf16 v[32:47], a[48:51], v[148:151], v[32:47]
    ds_read_b64_tr_b16 a[72:73], v163 offset:12288
    ds_read_b64_tr_b16 a[74:75], v163 offset:15360
    v_fma_f32 v124, v108, s52, v164
    v_fma_f32 v125, v109, s52, v164
    v_exp_f32 v140, v124
    v_exp_f32 v141, v125
    v_add_f32 v167, v167, v137
    v_add_f32 v166, v166, v138
    v_mfma_f32_32x32x16_bf16 v[48:63], a[52:55], v[148:151], v[48:63]
    ds_read_b64_tr_b16 a[76:77], v163 offset:18432
    ds_read_b64_tr_b16 a[78:79], v163 offset:21504
    v_fma_f32 v126, v110, s52, v164
    v_fma_f32 v127, v111, s52, v164
    v_exp_f32 v142, v126
    v_exp_f32 v143, v127
    v_add_f32 v167, v167, v139
    s_waitcnt lgkmcnt(8)
    v_mfma_f32_32x32x16_bf16 v[64:79], a[56:59], v[148:151], v[64:79]
    ds_read_b64_tr_b16 a[48:49], v162 offset:13312
    ds_read_b64_tr_b16 a[50:51], v162 offset:16384
    v_add_f32 v166, v166, v140
    v_add_f32 v167, v167, v141
    v_add_f32 v166, v166, v142
    v_add_f32 v167, v167, v143
    v_add_f32 v166, v166, v167
    v_cvt_pk_bf16_f32 v144, v128, v129
    v_cvt_pk_bf16_f32 v145, v130, v131
    v_cvt_pk_bf16_f32 v146, v132, v133
    v_mfma_f32_32x32x16_bf16 v[80:95], a[60:63], v[148:151], v[80:95]
    ds_read_b64_tr_b16 a[52:53], v162 offset:19456
    ds_read_b64_tr_b16 a[54:55], v162 offset:22528
    v_cvt_pk_bf16_f32 v147, v134, v135
    v_cvt_pk_bf16_f32 v148, v136, v137
    v_cvt_pk_bf16_f32 v149, v138, v139
    v_cvt_pk_bf16_f32 v150, v140, v141
    v_cvt_pk_bf16_f32 v151, v142, v143
    v_cmp_nge_f32 vcc, s54, v166
    s_cbranch_vccnz L_tail_slow
L_tail_ret:
    v_add_f32 v165, v165, v166
    v_mov_b32 v167, v165
    s_waitcnt lgkmcnt(8)
    v_mfma_f32_32x32x16_bf16 v[0:15], a[64:67], v[144:147], v[0:15]
    ds_read_b64_tr_b16 a[56:57], v163 offset:13312
    ds_read_b64_tr_b16 a[58:59], v163 offset:16384
    v_permlane32_swap_b32 v165, v167
    v_xor_b32 v113, 16, v172
    v_mfma_f32_32x32x16_bf16 v[0:15], a[68:71], v[148:151], v[0:15]
    ds_read_b64_tr_b16 a[60:61], v163 offset:19456
    ds_read_b64_tr_b16 a[62:63], v163 offset:22528
    v_add_f32 v165, v165, v167
    v_xor_b32 v114, 32, v172
    v_rcp_f32 v166, v165
    s_waitcnt lgkmcnt(8)
    v_mfma_f32_32x32x16_bf16 v[16:31], a[72:75], v[144:147], v[16:31]
    ds_read_b64_tr_b16 a[64:65], v162 offset:14336
    ds_read_b64_tr_b16 a[66:67], v162 offset:17408
    v_xor_b32 v115, 48, v172
    v_xor_b32 v116, 64, v172
    v_xor_b32 v117, 80, v172
    v_mfma_f32_32x32x16_bf16 v[16:31], a[76:79], v[148:151], v[16:31]
    ds_read_b64_tr_b16 a[68:69], v162 offset:20480
    ds_read_b64_tr_b16 a[70:71], v162 offset:23552
    v_xor_b32 v118, 96, v172
    v_xor_b32 v119, 112, v172
    v_pk_mul_f32 v[0:1], v[0:1], v[166:167] op_sel_hi:[1,0]
    v_pk_mul_f32 v[2:3], v[2:3], v[166:167] op_sel_hi:[1,0]
    v_cvt_pk_bf16_f32 v128, v0, v1
    v_cvt_pk_bf16_f32 v129, v2, v3
    ds_write_b64 v172, v[128:129]
    v_pk_mul_f32 v[4:5], v[4:5], v[166:167] op_sel_hi:[1,0]
    v_pk_mul_f32 v[6:7], v[6:7], v[166:167] op_sel_hi:[1,0]
    v_cvt_pk_bf16_f32 v130, v4, v5
    v_cvt_pk_bf16_f32 v131, v6, v7
    ds_write_b64 v113, v[130:131]
    v_pk_mul_f32 v[8:9], v[8:9], v[166:167] op_sel_hi:[1,0]
    v_pk_mul_f32 v[10:11], v[10:11], v[166:167] op_sel_hi:[1,0]
    v_cvt_pk_bf16_f32 v132, v8, v9
    v_cvt_pk_bf16_f32 v133, v10, v11
    ds_write_b64 v114, v[132:133]
    v_pk_mul_f32 v[12:13], v[12:13], v[166:167] op_sel_hi:[1,0]
    v_pk_mul_f32 v[14:15], v[14:15], v[166:167] op_sel_hi:[1,0]
    v_cvt_pk_bf16_f32 v134, v12, v13
    v_cvt_pk_bf16_f32 v135, v14, v15
    ds_write_b64 v115, v[134:135]
    v_pk_mul_f32 v[16:17], v[16:17], v[166:167] op_sel_hi:[1,0]
    v_pk_mul_f32 v[18:19], v[18:19], v[166:167] op_sel_hi:[1,0]
    v_cvt_pk_bf16_f32 v136, v16, v17
    v_cvt_pk_bf16_f32 v137, v18, v19
    ds_write_b64 v116, v[136:137]
    v_pk_mul_f32 v[20:21], v[20:21], v[166:167] op_sel_hi:[1,0]
    v_pk_mul_f32 v[22:23], v[22:23], v[166:167] op_sel_hi:[1,0]
    v_cvt_pk_bf16_f32 v138, v20, v21
    v_cvt_pk_bf16_f32 v139, v22, v23
    ds_write_b64 v117, v[138:139]
    v_pk_mul_f32 v[24:25], v[24:25], v[166:167] op_sel_hi:[1,0]
    v_pk_mul_f32 v[26:27], v[26:27], v[166:167] op_sel_hi:[1,0]
    v_cvt_pk_bf16_f32 v140, v24, v25
    v_cvt_pk_bf16_f32 v141, v26, v27
    ds_write_b64 v118, v[140:141]
    v_pk_mul_f32 v[28:29], v[28:29], v[166:167] op_sel_hi:[1,0]
    v_pk_mul_f32 v[30:31], v[30:31], v[166:167] op_sel_hi:[1,0]
    v_cvt_pk_bf16_f32 v142, v28, v29
    v_cvt_pk_bf16_f32 v143, v30, v31
    ds_write_b64 v119, v[142:143]
    ds_read_b128 a[0:3], v173 offset:0
    ds_read_b128 a[4:7], v173 offset:1024
    ds_read_b128 a[8:11], v173 offset:2048
    ds_read_b128 a[12:15], v173 offset:3072
    s_waitcnt lgkmcnt(14)
    v_mfma_f32_32x32x16_bf16 v[32:47], a[48:51], v[144:147], v[32:47]
    ds_read_b64_tr_b16 a[72:73], v163 offset:14336
    ds_read_b64_tr_b16 a[74:75], v163 offset:17408
    v_mfma_f32_32x32x16_bf16 v[32:47], a[52:55], v[148:151], v[32:47]
    ds_read_b64_tr_b16 a[76:77], v163 offset:20480
    ds_read_b64_tr_b16 a[78:79], v163 offset:23552
    s_waitcnt lgkmcnt(14)
    v_mfma_f32_32x32x16_bf16 v[48:63], a[56:59], v[144:147], v[48:63]
    v_mfma_f32_32x32x16_bf16 v[48:63], a[60:63], v[148:151], v[48:63]
    s_waitcnt lgkmcnt(4)
    buffer_store_dwordx4 a[0:3], v174, s[24:27], s55 offen offset:0 sc0 sc1
    s_nop 4
    v_pk_mul_f32 v[32:33], v[32:33], v[166:167] op_sel_hi:[1,0]
    v_pk_mul_f32 v[34:35], v[34:35], v[166:167] op_sel_hi:[1,0]
    v_cvt_pk_bf16_f32 v128, v32, v33
    v_cvt_pk_bf16_f32 v129, v34, v35
    ds_write_b64 v172, v[128:129]
    v_pk_mul_f32 v[36:37], v[36:37], v[166:167] op_sel_hi:[1,0]
    v_pk_mul_f32 v[38:39], v[38:39], v[166:167] op_sel_hi:[1,0]
    v_cvt_pk_bf16_f32 v130, v36, v37
    v_cvt_pk_bf16_f32 v131, v38, v39
    ds_write_b64 v113, v[130:131]
    buffer_store_dwordx4 a[4:7], v174, s[24:27], s13 offen offset:0 sc0 sc1
    v_pk_mul_f32 v[40:41], v[40:41], v[166:167] op_sel_hi:[1,0]
    v_pk_mul_f32 v[42:43], v[42:43], v[166:167] op_sel_hi:[1,0]
    v_cvt_pk_bf16_f32 v132, v40, v41
    v_cvt_pk_bf16_f32 v133, v42, v43
    ds_write_b64 v114, v[132:133]
    v_pk_mul_f32 v[44:45], v[44:45], v[166:167] op_sel_hi:[1,0]
    v_pk_mul_f32 v[46:47], v[46:47], v[166:167] op_sel_hi:[1,0]
    v_cvt_pk_bf16_f32 v134, v44, v45
    v_cvt_pk_bf16_f32 v135, v46, v47
    ds_write_b64 v115, v[134:135]
    buffer_store_dwordx4 a[8:11], v174, s[24:27], s14 offen offset:0 sc0 sc1
    v_pk_mul_f32 v[48:49], v[48:49], v[166:167] op_sel_hi:[1,0]
    v_pk_mul_f32 v[50:51], v[50:51], v[166:167] op_sel_hi:[1,0]
    v_cvt_pk_bf16_f32 v136, v48, v49
    v_cvt_pk_bf16_f32 v137, v50, v51
    ds_write_b64 v116, v[136:137]
    v_pk_mul_f32 v[52:53], v[52:53], v[166:167] op_sel_hi:[1,0]
    v_pk_mul_f32 v[54:55], v[54:55], v[166:167] op_sel_hi:[1,0]
    v_cvt_pk_bf16_f32 v138, v52, v53
    v_cvt_pk_bf16_f32 v139, v54, v55
    ds_write_b64 v117, v[138:139]
    buffer_store_dwordx4 a[12:15], v174, s[24:27], s15 offen offset:0 sc0 sc1
    v_pk_mul_f32 v[56:57], v[56:57], v[166:167] op_sel_hi:[1,0]
    v_pk_mul_f32 v[58:59], v[58:59], v[166:167] op_sel_hi:[1,0]
    v_cvt_pk_bf16_f32 v140, v56, v57
    v_cvt_pk_bf16_f32 v141, v58, v59
    ds_write_b64 v118, v[140:141]
    v_pk_mul_f32 v[60:61], v[60:61], v[166:167] op_sel_hi:[1,0]
    v_pk_mul_f32 v[62:63], v[62:63], v[166:167] op_sel_hi:[1,0]
    v_cvt_pk_bf16_f32 v142, v60, v61
    v_cvt_pk_bf16_f32 v143, v62, v63
    ds_write_b64 v119, v[142:143]
    ds_read_b128 a[16:19], v173 offset:0
    ds_read_b128 a[20:23], v173 offset:1024
    ds_read_b128 a[24:27], v173 offset:2048
    ds_read_b128 a[28:31], v173 offset:3072
    v_mfma_f32_32x32x16_bf16 v[64:79], a[64:67], v[144:147], v[64:79]
    v_mfma_f32_32x32x16_bf16 v[64:79], a[68:71], v[148:151], v[64:79]
    s_waitcnt lgkmcnt(12)
    v_mfma_f32_32x32x16_bf16 v[80:95], a[72:75], v[144:147], v[80:95]
    v_mfma_f32_32x32x16_bf16 v[80:95], a[76:79], v[148:151], v[80:95]
    s_waitcnt lgkmcnt(0)
    buffer_store_dwordx4 a[16:19], v174, s[24:27], s55 offen offset:128 sc0 sc1
    s_nop 6
    v_pk_mul_f32 v[64:65], v[64:65], v[166:167] op_sel_hi:[1,0]
    v_pk_mul_f32 v[66:67], v[66:67], v[166:167] op_sel_hi:[1,0]
    v_cvt_pk_bf16_f32 v128, v64, v65
    v_cvt_pk_bf16_f32 v129, v66, v67
    ds_write_b64 v172, v[128:129]
    v_pk_mul_f32 v[68:69], v[68:69], v[166:167] op_sel_hi:[1,0]
    v_pk_mul_f32 v[70:71], v[70:71], v[166:167] op_sel_hi:[1,0]
    v_cvt_pk_bf16_f32 v130, v68, v69
    v_cvt_pk_bf16_f32 v131, v70, v71
    ds_write_b64 v113, v[130:131]
    buffer_store_dwordx4 a[20:23], v174, s[24:27], s13 offen offset:128 sc0 sc1
    v_pk_mul_f32 v[72:73], v[72:73], v[166:167] op_sel_hi:[1,0]
    v_pk_mul_f32 v[74:75], v[74:75], v[166:167] op_sel_hi:[1,0]
    v_cvt_pk_bf16_f32 v132, v72, v73
    v_cvt_pk_bf16_f32 v133, v74, v75
    ds_write_b64 v114, v[132:133]
    v_pk_mul_f32 v[76:77], v[76:77], v[166:167] op_sel_hi:[1,0]
    v_pk_mul_f32 v[78:79], v[78:79], v[166:167] op_sel_hi:[1,0]
    v_cvt_pk_bf16_f32 v134, v76, v77
    v_cvt_pk_bf16_f32 v135, v78, v79
    ds_write_b64 v115, v[134:135]
    buffer_store_dwordx4 a[24:27], v174, s[24:27], s14 offen offset:128 sc0 sc1
    v_pk_mul_f32 v[80:81], v[80:81], v[166:167] op_sel_hi:[1,0]
    v_pk_mul_f32 v[82:83], v[82:83], v[166:167] op_sel_hi:[1,0]
    v_cvt_pk_bf16_f32 v136, v80, v81
    v_cvt_pk_bf16_f32 v137, v82, v83
    ds_write_b64 v116, v[136:137]
    v_pk_mul_f32 v[84:85], v[84:85], v[166:167] op_sel_hi:[1,0]
    v_pk_mul_f32 v[86:87], v[86:87], v[166:167] op_sel_hi:[1,0]
    v_cvt_pk_bf16_f32 v138, v84, v85
    v_cvt_pk_bf16_f32 v139, v86, v87
    ds_write_b64 v117, v[138:139]
    buffer_store_dwordx4 a[28:31], v174, s[24:27], s15 offen offset:128 sc0 sc1
    v_pk_mul_f32 v[88:89], v[88:89], v[166:167] op_sel_hi:[1,0]
    v_pk_mul_f32 v[90:91], v[90:91], v[166:167] op_sel_hi:[1,0]
    v_cvt_pk_bf16_f32 v140, v88, v89
    v_cvt_pk_bf16_f32 v141, v90, v91
    ds_write_b64 v118, v[140:141]
    v_pk_mul_f32 v[92:93], v[92:93], v[166:167] op_sel_hi:[1,0]
    v_pk_mul_f32 v[94:95], v[94:95], v[166:167] op_sel_hi:[1,0]
    v_cvt_pk_bf16_f32 v142, v92, v93
    v_cvt_pk_bf16_f32 v143, v94, v95
    ds_write_b64 v119, v[142:143]
    ds_read_b128 a[32:35], v173 offset:0
    ds_read_b128 a[36:39], v173 offset:1024
    ds_read_b128 a[40:43], v173 offset:2048
    ds_read_b128 a[44:47], v173 offset:3072
    s_waitcnt lgkmcnt(0)
    buffer_store_dwordx4 a[32:35], v174, s[24:27], s55 offen offset:256 sc0 sc1
    buffer_store_dwordx4 a[36:39], v174, s[24:27], s13 offen offset:256 sc0 sc1
    buffer_store_dwordx4 a[40:43], v174, s[24:27], s14 offen offset:256 sc0 sc1
    buffer_store_dwordx4 a[44:47], v174, s[24:27], s15 offen offset:256 sc0 sc1
    s_add_u32 s50, s50, 24576
    s_cmp_eq_u32 s50, 147456
    s_cselect_b32 s50, 0, s50
    s_branch L_nextjob
L_idle:
    s_add_u32 s51, s37, 2
L_idle_loop:
    s_barrier
    s_add_u32 s50, s50, 24576
    s_cmp_eq_u32 s50, 147456
    s_cselect_b32 s50, 0, s50
    s_sub_u32 s51, s51, 1
    s_cmp_lg_u32 s51, 0
    s_cbranch_scc1 L_idle_loop
L_nextjob:
    s_cmp_lg_u32 s60, 0
    s_cbranch_scc1 L_fin
    s_cmp_eq_u32 s45, 0
    s_cbranch_scc1 L_fin
    s_mov_b32 s60, 1
    s_mov_b64 s[32:33], s[40:41]
    s_mov_b64 s[34:35], s[42:43]
    s_mov_b64 s[36:37], s[44:45]
    s_mov_b64 s[38:39], s[46:47]
    s_branch L_job
L_smB:
    v_fma_f32 v120, v120, s52, v164
    v_fma_f32 v121, v121, s52, v164
    v_fma_f32 v122, v122, s52, v164
    v_fma_f32 v123, v123, s52, v164
    v_fma_f32 v124, v124, s52, v164
    v_fma_f32 v125, v125, s52, v164
    v_fma_f32 v126, v126, s52, v164
    v_fma_f32 v127, v127, s52, v164
    v_exp_f32 v136, v120
    v_exp_f32 v137, v121
    v_exp_f32 v138, v122
    v_exp_f32 v139, v123
    v_exp_f32 v140, v124
    v_exp_f32 v141, v125
    v_exp_f32 v142, v126
    v_exp_f32 v143, v127
    s_nop 0
    v_add_f32 v165, v165, v136
    v_add_f32 v165, v165, v137
    v_add_f32 v165, v165, v138
    v_add_f32 v165, v165, v139
    v_add_f32 v165, v165, v140
    v_add_f32 v165, v165, v141
    v_add_f32 v165, v165, v142
    v_add_f32 v165, v165, v143
    v_cvt_pk_bf16_f32 v148, v136, v137
    v_cvt_pk_bf16_f32 v149, v138, v139
    v_cvt_pk_bf16_f32 v150, v140, v141
    v_cvt_pk_bf16_f32 v151, v142, v143
    s_branch L_smB_ret
L_ks1:
    s_nop 15
    ds_read_b64_tr_b16 a[72:73], v162 offset:6144
    ds_read_b64_tr_b16 a[74:75], v162 offset:9216
    ds_read_b64_tr_b16 a[76:77], v163 offset:6144
    ds_read_b64_tr_b16 a[78:79], v163 offset:9216
    s_waitcnt lgkmcnt(0)
    v_mfma_f32_32x32x16_bf16 v[0:15], a[72:75], v[148:151], v[0:15]
    v_mfma_f32_32x32x16_bf16 v[16:31], a[76:79], v[148:151], v[16:31]
    s_nop 15
    ds_read_b64_tr_b16 a[72:73], v162 offset:7168
    ds_read_b64_tr_b16 a[74:75], v162 offset:10240
    ds_read_b64_tr_b16 a[76:77], v163 offset:7168
    ds_read_b64_tr_b16 a[78:79], v163 offset:10240
    s_waitcnt lgkmcnt(0)
    v_mfma_f32_32x32x16_bf16 v[32:47], a[72:75], v[148:151], v[32:47]
    v_mfma_f32_32x32x16_bf16 v[48:63], a[76:79], v[148:151], v[48:63]
    s_nop 15
    ds_read_b64_tr_b16 a[72:73], v162 offset:8192
    ds_read_b64_tr_b16 a[74:75], v162 offset:11264
    ds_read_b64_tr_b16 a[76:77], v163 offset:8192
    ds_read_b64_tr_b16 a[78:79], v163 offset:11264
    s_waitcnt lgkmcnt(0)
    v_mfma_f32_32x32x16_bf16 v[64:79], a[72:75], v[148:151], v[64:79]
    v_mfma_f32_32x32x16_bf16 v[80:95], a[76:79], v[148:151], v[80:95]
    s_nop 15
    s_branch L_ks1_ret
L_body_slow:
    s_swappc_b64 s[56:57], s[58:59]
    s_branch L_body_ret
L_tail_slow:
    s_swappc_b64 s[56:57], s[58:59]
    s_branch L_tail_ret
L_b0_slow:
    s_swappc_b64 s[56:57], s[58:59]
    s_branch L_b0_ret
L_slow:
    s_nop 15
    s_nop 7
    v_max3_f32 v166, v112, v113, v114
    v_max3_f32 v167, v115, v116, v117
    v_max3_f32 v166, v166, v118, v119
    v_max3_f32 v167, v167, v120, v121
    v_max3_f32 v166, v166, v122, v123
    v_max3_f32 v167, v167, v124, v125
    v_max3_f32 v166, v166, v126, v127
    v_max3_f32 v166, v166, v167, 0
    v_mov_b32 v167, v166
    s_nop 1
    v_permlane32_swap_b32 v166, v167
    v_max_f32 v169, v166, v167
    v_sub_f32 v170, 0, v169
    v_exp_f32 v170, v170
    v_sub_f32 v164, v164, v169
    v_mul_f32 v165, v165, v170
    v_mul_f32 v0, v0, v170
    v_mul_f32 v1, v1, v170
    v_mul_f32 v2, v2, v170
    v_mul_f32 v3, v3, v170
    v_mul_f32 v4, v4, v170
    v_mul_f32 v5, v5, v170
    v_mul_f32 v6, v6, v170
    v_mul_f32 v7, v7, v170
    v_mul_f32 v8, v8, v170
    v_mul_f32 v9, v9, v170
    v_mul_f32 v10, v10, v170
    v_mul_f32 v11, v11, v170
    v_mul_f32 v12, v12, v170
    v_mul_f32 v13, v13, v170
    v_mul_f32 v14, v14, v170
    v_mul_f32 v15, v15, v170
    v_mul_f32 v16, v16, v170
    v_mul_f32 v17, v17, v170
    v_mul_f32 v18, v18, v170
    v_mul_f32 v19, v19, v170
    v_mul_f32 v20, v20, v170
    v_mul_f32 v21, v21, v170
    v_mul_f32 v22, v22, v170
    v_mul_f32 v23, v23, v170
    v_mul_f32 v24, v24, v170
    v_mul_f32 v25, v25, v170
    v_mul_f32 v26, v26, v170
    v_mul_f32 v27, v27, v170
    v_mul_f32 v28, v28, v170
    v_mul_f32 v29, v29, v170
    v_mul_f32 v30, v30, v170
    v_mul_f32 v31, v31, v170
    v_mul_f32 v32, v32, v170
    v_mul_f32 v33, v33, v170
    v_mul_f32 v34, v34, v170
    v_mul_f32 v35, v35, v170
    v_mul_f32 v36, v36, v170
    v_mul_f32 v37, v37, v170
    v_mul_f32 v38, v38, v170
    v_mul_f32 v39, v39, v170
    v_mul_f32 v40, v40, v170
    v_mul_f32 v41, v41, v170
    v_mul_f32 v42, v42, v170
    v_mul_f32 v43, v43, v170
    v_mul_f32 v44, v44, v170
    v_mul_f32 v45, v45, v170
    v_mul_f32 v46, v46, v170
    v_mul_f32 v47, v47, v170
    v_mul_f32 v48, v48, v170
    v_mul_f32 v49, v49, v170
    v_mul_f32 v50, v50, v170
    v_mul_f32 v51, v51, v170
    v_mul_f32 v52, v52, v170
    v_mul_f32 v53, v53, v170
    v_mul_f32 v54, v54, v170
    v_mul_f32 v55, v55, v170
    v_mul_f32 v56, v56, v170
    v_mul_f32 v57, v57, v170
    v_mul_f32 v58, v58, v170
    v_mul_f32 v59, v59, v170
    v_mul_f32 v60, v60, v170
    v_mul_f32 v61, v61, v170
    v_mul_f32 v62, v62, v170
    v_mul_f32 v63, v63, v170
    v_mul_f32 v64, v64, v170
    v_mul_f32 v65, v65, v170
    v_mul_f32 v66, v66, v170
    v_mul_f32 v67, v67, v170
    v_mul_f32 v68, v68, v170
    v_mul_f32 v69, v69, v170
    v_mul_f32 v70, v70, v170
    v_mul_f32 v71, v71, v170
    v_mul_f32 v72, v72, v170
    v_mul_f32 v73, v73, v170
    v_mul_f32 v74, v74, v170
    v_mul_f32 v75, v75, v170
    v_mul_f32 v76, v76, v170
    v_mul_f32 v77, v77, v170
    v_mul_f32 v78, v78, v170
    v_mul_f32 v79, v79, v170
    v_mul_f32 v80, v80, v170
    v_mul_f32 v81, v81, v170
    v_mul_f32 v82, v82, v170
    v_mul_f32 v83, v83, v170
    v_mul_f32 v84, v84, v170
    v_mul_f32 v85, v85, v170
    v_mul_f32 v86, v86, v170
    v_mul_f32 v87, v87, v170
    v_mul_f32 v88, v88, v170
    v_mul_f32 v89, v89, v170
    v_mul_f32 v90, v90, v170
    v_mul_f32 v91, v91, v170
    v_mul_f32 v92, v92, v170
    v_mul_f32 v93, v93, v170
    v_mul_f32 v94, v94, v170
    v_mul_f32 v95, v95, v170
    v_sub_f32 v128, v112, v169
    v_sub_f32 v129, v113, v169
    v_sub_f32 v130, v114, v169
    v_sub_f32 v131, v115, v169
    v_sub_f32 v132, v116, v169
    v_sub_f32 v133, v117, v169
    v_sub_f32 v134, v118, v169
    v_sub_f32 v135, v119, v169
    v_sub_f32 v136, v120, v169
    v_sub_f32 v137, v121, v169
    v_sub_f32 v138, v122, v169
    v_sub_f32 v139, v123, v169
    v_sub_f32 v140, v124, v169
    v_sub_f32 v141, v125, v169
    v_sub_f32 v142, v126, v169
    v_sub_f32 v143, v127, v169
    v_exp_f32 v128, v128
    v_exp_f32 v129, v129
    v_exp_f32 v130, v130
    v_exp_f32 v131, v131
    v_exp_f32 v132, v132
    v_exp_f32 v133, v133
    v_exp_f32 v134, v134
    v_exp_f32 v135, v135
    v_exp_f32 v136, v136
    v_exp_f32 v137, v137
    v_exp_f32 v138, v138
    v_exp_f32 v139, v139
    v_exp_f32 v140, v140
    v_exp_f32 v141, v141
    v_exp_f32 v142, v142
    v_exp_f32 v143, v143
    s_nop 0
    v_add_f32 v166, v128, v129
    v_add_f32 v166, v166, v130
    v_add_f32 v166, v166, v131
    v_add_f32 v166, v166, v132
    v_add_f32 v166, v166, v133
    v_add_f32 v166, v166, v134
    v_add_f32 v166, v166, v135
    v_add_f32 v166, v166, v136
    v_add_f32 v166, v166, v137
    v_add_f32 v166, v166, v138
    v_add_f32 v166, v166, v139
    v_add_f32 v166, v166, v140
    v_add_f32 v166, v166, v141
    v_add_f32 v166, v166, v142
    v_add_f32 v166, v166, v143
    v_cvt_pk_bf16_f32 v144, v128, v129
    v_cvt_pk_bf16_f32 v145, v130, v131
    v_cvt_pk_bf16_f32 v146, v132, v133
    v_cvt_pk_bf16_f32 v147, v134, v135
    v_cvt_pk_bf16_f32 v148, v136, v137
    v_cvt_pk_bf16_f32 v149, v138, v139
    v_cvt_pk_bf16_f32 v150, v140, v141
    v_cvt_pk_bf16_f32 v151, v142, v143
    s_nop 1
    s_setpc_b64 s[56:57]
L_fin:
L_end:
    s_endpgm
.p2align 6
.type L_table,@object
L_table:
    .long 8110080, 8110080, 9486336, 8896512, 9492480, 8, 1, 4, 1462272, 1462272, 2248704, 2052096, 2310144, 5, 10, 3
    .long 8896512, 8110080, 9486336, 9492480, 9492480, 8, 1, 4, 2052096, 1462272, 2248704, 2310144, 2310144, 5, 10, 131074
    .long 11458560, 11458560, 12638208, 12244992, 12644352, 7, 1, 4, 4110336, 4110336, 5093376, 4700160, 5130240, 6, 6, 3
    .long 12244992, 11458560, 12638208, 12644352, 12644352, 7, 1, 3, 4700160, 4110336, 5093376, 5130240, 5130240, 6, 6, 131075
    .long 5130240, 5130240, 8079360, 5916672, 8110080, 16, 5, 4, 0, 0, 0, 0, 0, 0, 0, 0
    .long 5916672, 5130240, 8079360, 6703104, 8110080, 16, 5, 196612, 0, 0, 0, 0, 0, 0, 0, 0
    .long 6703104, 5130240, 8079360, 7489536, 8110080, 16, 5, 458756, 0, 0, 0, 0, 0, 0, 0, 0
    .long 7489536, 5130240, 8079360, 8110080, 8110080, 16, 5, 720900, 0, 0, 0, 0, 0, 0, 0, 0
    .long 2310144, 2310144, 4079616, 3096576, 4110336, 10, 5, 33555204, 0, 0, 0, 0, 0, 0, 0, 0
    .long 3096576, 2310144, 4079616, 3686400, 4110336, 10, 5, 33555203, 0, 0, 0, 0, 0, 0, 0, 0
    .long 3686400, 2310144, 4079616, 4110336, 4110336, 10, 5, 33555203, 0, 0, 0, 0, 0, 0, 0, 0
    .long 9492480, 9492480, 11261952, 10278912, 11458560, 10, 32, 33554948, 0, 0, 0, 0, 0, 0, 0, 0
    .long 10278912, 9492480, 11261952, 10868736, 11458560, 10, 32, 33751555, 0, 0, 0, 0, 0, 0, 0, 0
    .long 10868736, 9492480, 11261952, 11458560, 11458560, 10, 32, 33948163, 0, 0, 0, 0, 0, 0, 0, 0
    .long 0, 0, 1376256, 786432, 1462272, 8, 14, 33555460, 0, 0, 0, 0, 0, 0, 0, 0
    .long 786432, 0, 1376256, 1462272, 1462272, 8, 14, 33555460, 0, 0, 0, 0, 0, 0, 0, 0
.section .rodata,"a"
.p2align 6
.amdhsa_kernel standalone__varlen_attn_packed__ragged_kernel
  .amdhsa_next_free_vgpr 256
  .amdhsa_next_free_sgpr 102
  .amdhsa_accum_offset 176
  .amdhsa_group_segment_fixed_size 0
  .amdhsa_kernarg_size 56
  .amdhsa_user_sgpr_count 2
  .amdhsa_user_sgpr_kernarg_segment_ptr 1
  .amdhsa_system_sgpr_workgroup_id_x 1
.end_amdhsa_kernel
```
